```python
import torch

def _softmax(x, axis=-1):
    return torch.softmax(x, dim=axis)
def _gelu(x):
    return torch.nn.functional.gelu(x, approximate="tanh")
def _silu(x):
    return torch.nn.functional.silu(x)
def _sigmoid(x):
    return torch.sigmoid(x)
def _layernorm(x, axis=-1, eps=1e-5):
    m = x.mean(dim=axis, keepdim=True)
    v = x.var(dim=axis, keepdim=True, unbiased=False)
    return (x - m) / torch.sqrt(v + eps)
def _scatter_add(tgt, idx, src, axis=0):
    return tgt.clone().index_add_(axis, idx, src)
def _segment_sum(src, seg, n):
    out = torch.zeros((n,) + src.shape[1:], dtype=src.dtype)
    return out.index_add_(0, seg, src)
def _pad(x, pw):
    flat = tuple(v for pair in reversed(pw) for v in pair)
    return torch.nn.functional.pad(x, flat)

kernel_name = 'standalone__normalfloat_lut_codebook_lookup__prompt'

def setup_inputs():

    _w = (lambda a: (lambda t: t.to(torch.bfloat16) if t.is_floating_point() else t)(torch.as_tensor(a)))
    B, S, D, F = 1, 2048, 1024, 3584
    G = 32 if 32 > 0 else D
    D = (D // G) * G
    ng = D // G
    nf4 = torch.tensor([
        -1.0, -0.6961928009986877, -0.5250730514526367, -0.39491748809814453,
        -0.28444138169288635, -0.18477343022823334, -0.09105003625154495, 0.0,
        0.07958029955625534, 0.16093020141124725, 0.24611230194568634, 0.33791524171829224,
        0.44070982933044434, 0.5626170039176941, 0.7229568362236023, 1.0
    ], dtype=float)
    qw = torch.randint(0, 16, (D, F)).to(torch.int64)
    absmax = (torch.abs((lambda *s: torch.randn(*s, dtype=torch.bfloat16) * 0.05)(ng, F)) + 0.01).to(float)
    return {
        "x": _w((lambda *s: torch.randn(*s, dtype=torch.bfloat16) * 0.05)(B, S, D)),
        "qw": _w(qw),
        "codebook": _w(nf4),
        "absmax": _w(absmax),
    }

def reference(x, qw, codebook, absmax):
    B, S, D = x.shape
    ng, F = absmax.shape
    G = D // ng
    w_nf = codebook[qw]
    s = (lambda x, n, axis: torch.repeat_interleave(x, n, dim=axis))(absmax, G, axis=0)
    w = (lambda x, dt: x.to(dt))(w_nf * s, x.dtype)
    return torch.einsum("bsd,df->bsf", x, w)
```

```asm
; @launch grid=(256,1,1) block=(512,1,1) lds=147712
.amdgcn_target "amdgcn-amd-amdhsa--gfx950"
.text
.globl standalone__normalfloat_lut_codebook_lookup__prompt_kernel
.p2align 8
.type standalone__normalfloat_lut_codebook_lookup__prompt_kernel,@function
standalone__normalfloat_lut_codebook_lookup__prompt_kernel:
  s_cmp_ge_u32 s2, 256
  s_cbranch_scc1 L_end
  s_load_dwordx8 s[24:31], s[0:1], 0
  s_getpc_b64 s[82:83]
L_pc:
  v_lshlrev_b32 v1, 7, v0
  v_min_u32 v1, L_end-L_pc, v1
  global_load_dword v27, v1, s[82:83]
  s_load_dwordx2 s[32:33], s[0:1], 32
  s_load_dwordx2 s[60:61], s[0:1], 48
  v_lshrrev_b32 v1, 6, v0
  v_and_b32 v0, 63, v0
  s_and_b32 s35, s2, 7
  s_lshr_b32 s36, s2, 3
  v_readfirstlane_b32 s34, v1
  s_mov_b32 s7, 0x20000
  s_mov_b32 s11, 0x20000
  s_mov_b32 s15, 0x20000
  s_mov_b32 s19, 0x20000
  s_mov_b32 s23, 0x20000
  s_mov_b32 s87, 0x20000
  s_mov_b32 s95, 0x20000
  s_mov_b32 s6, 4194304
  s_mov_b32 s10, 14680064
  s_mov_b32 s14, 229376
  s_mov_b32 s18, 14680064
  s_mov_b32 s22, 32
  s_mov_b32 s86, 7340032
  s_mov_b32 s94, 14336
  v_lshrrev_b32 v10, 5, v0
  v_and_b32 v11, 31, v0
  v_mul_u32_u24 v13, 114688, v10
  v_lshl_add_u32 v13, v11, 4, v13
  v_add_u32 v16, 0, v13
  v_add_u32 v17, 14336, v13
  v_add_u32 v18, 28672, v13
  v_add_u32 v19, 43008, v13
  v_add_u32 v20, 57344, v13
  v_add_u32 v21, 71680, v13
  v_add_u32 v22, 86016, v13
  v_add_u32 v23, 100352, v13
  v_lshlrev_b32 v24, 3, v11
  v_lshlrev_b32 v26, 4, v0
  v_lshlrev_b32 v28, 3, v0
  v_lshlrev_b32 v30, 1, v0
  s_sub_u32 s37, s36, 4
  s_lshr_b32 s38, s35, 1
  s_mul_i32 s38, s38, 7
  s_and_b32 s39, s35, 1
  s_lshl_b32 s39, s39, 2
  s_and_b32 s88, s37, 3
  s_add_u32 s88, s88, s39
  s_lshr_b32 s89, s37, 2
  s_add_u32 s90, s89, s88
  s_and_b32 s90, s90, 3
  s_add_u32 s89, s89, s38
  s_or_b32 s91, s90, s39
  s_and_b32 s57, s34, 3
  s_lshl_b32 s56, s57, 13
  s_add_u32 s56, s56, 256
  s_mul_i32 s40, s91, 112
  s_lshl_b32 s41, s89, 2
  s_add_u32 s40, s40, s41
  s_add_u32 s40, s40, s57
  s_lshl_b32 s41, s57, 5
  s_add_u32 s41, s41, s2
  s_add_u32 s41, s41, 896
  s_cmp_lt_u32 s36, 4
  s_cselect_b32 s40, s41, s40
  s_mul_i32 s41, s40, 9363
  s_lshr_b32 s41, s41, 20
  s_mul_i32 s42, s41, 112
  s_sub_u32 s42, s40, s42
  s_lshr_b32 s38, s42, 2
  s_and_b32 s37, s42, 3
  s_lshl_b32 s43, s41, 2
  s_add_u32 s43, s43, s37
  s_mul_i32 s44, s43, 229376
  s_lshl_b32 s37, s38, 9
  s_add_u32 s44, s44, s37
  s_lshr_b32 s45, s43, 1
  s_mul_i32 s45, s45, 7168
  s_lshl_b32 s37, s38, 8
  s_add_u32 s45, s45, s37
  s_lshl_b32 s46, s43, 12
  s_lshl_b32 s37, s38, 18
  s_add_u32 s46, s46, s37
  s_lshl_b32 s47, s42, 7
  s_lshl_b32 s37, s41, 3
  s_add_u32 s47, s47, s37
  s_lshl_b32 s43, s42, 7
  s_add_u32 s43, s43, 0x50000
  s_waitcnt lgkmcnt(0)
  s_mov_b32 s8, s26
  s_mov_b32 s9, s27
  s_mov_b32 s12, s30
  s_mov_b32 s13, s31
  s_mov_b32 s20, s28
  s_mov_b32 s21, s29
  s_mov_b32 s4, s24
  s_mov_b32 s5, s25
  s_mov_b32 s16, s32
  s_mov_b32 s17, s33
  s_add_u32 s84, s60, 0x100000
  s_addc_u32 s85, s61, 0
  s_add_u32 s92, s60, 0x40000
  s_addc_u32 s93, s61, 0
  s_cmp_lt_u32 s34, 4
  s_cbranch_scc1 L_mfma
  s_setprio 3
  buffer_load_ushort v31, v30, s[20:23], 0 offen
  buffer_load_dwordx2 v[96:97], v24, s[12:15], s45 offen
  buffer_load_dwordx4 v[64:67], v16, s[8:11], s44 offen
  buffer_load_dwordx4 v[68:71], v17, s[8:11], s44 offen
  buffer_load_dwordx4 v[72:75], v18, s[8:11], s44 offen
  buffer_load_dwordx4 v[76:79], v19, s[8:11], s44 offen
  buffer_load_dwordx4 v[80:83], v20, s[8:11], s44 offen
  buffer_load_dwordx4 v[84:87], v21, s[8:11], s44 offen
  buffer_load_dwordx4 v[88:91], v22, s[8:11], s44 offen
  buffer_load_dwordx4 v[92:95], v23, s[8:11], s44 offen
  s_load_dwordx2 s[48:49], s[60:61], s43
  s_cmp_lt_u32 s36, 4
  s_cbranch_scc1 L_help
  s_barrier
  v_lshrrev_b32 v12, 3, v0
  v_lshlrev_b32 v12, 11, v12
  v_lshrrev_b32 v13, 4, v0
  v_and_b32 v14, 7, v0
  v_xor_b32 v13, v13, v14
  v_lshl_add_u32 v12, v13, 4, v12
  s_lshl_b32 s50, s88, 2
  s_add_u32 s50, s50, s57
  s_lshl_b32 s50, s50, 17
  v_add_u32 v12, s50, v12
  v_xor_b32 v13, 64, v12
  v_add_u32 v2, 0x0, v12
  v_add_u32 v3, 0x3c00, v13
  v_add_u32 v4, 0x7800, v12
  v_add_u32 v5, 0xb400, v13
  v_add_u32 v6, 0x10000, v12
  v_add_u32 v7, 0x13c00, v13
  v_add_u32 v8, 0x17800, v12
  v_add_u32 v9, 0x1b400, v13
  s_mov_b32 s75, s43
  s_lshl_b32 s74, s42, 7
  s_lshl_b32 s53, s57, 12
  s_add_u32 s58, s53, 33024
  v_add_u32 v25, s58, v26
  s_lshl_b32 s73, s89, 18
  s_add_u32 s73, s73, s53
  v_mov_b32 v14, 0x7fffffff
  v_cmp_gt_u32 vcc, 16, v0
  s_lshl_b32 s50, s90, 2
  s_lshr_b32 s50, 0x32103210, s50
  v_cndmask_b32 v29, v14, v28, vcc
  s_and_b32 s50, s50, 0xffff
  s_mul_i32 s51, s39, 0x1111
  s_or_b32 s50, s50, s51
  s_xor_b32 s72, s50, 0x4444
  s_mov_b32 s51, s72
  s_bitcmp1_b32 s90, 0
  s_mov_b32 s71, 0xfedc0000
  s_cselect_b32 s71, 0xefcd0000, s71
  s_and_b32 s52, s51, 0x3333
  s_or_b32 s52, s52, 0x8888
  s_or_b32 s71, s71, s52
  s_lshl_b32 s52, s51, 16
  s_or_b32 s70, s50, s52
  buffer_load_dwordx2 v[50:51], v29, s[92:95], s74 offen sc1
  v_lshlrev_b32 v30, 2, v0
  s_waitcnt vmcnt(10)
  v_lshlrev_b32 v31, 16, v31
  ds_write_b32 v30, v31 offset:0
  s_waitcnt lgkmcnt(0)
  s_add_u32 s96, s48, 0x9e3779b9
  s_add_u32 s97, s49, 0x7feb352d
  v_mov_b32 v30, s96
  v_mov_b32 v31, s97
  s_waitcnt vmcnt(1)
  v_lshlrev_b32 v64, 2, v64
  v_lshlrev_b32 v68, 2, v68
  v_lshlrev_b32 v72, 2, v72
  v_lshlrev_b32 v76, 2, v76
  v_lshlrev_b32 v80, 2, v80
  v_lshlrev_b32 v84, 2, v84
  v_lshlrev_b32 v88, 2, v88
  v_lshlrev_b32 v92, 2, v92
  ds_read_b32 v64, v64 offset:0
  ds_read_b32 v68, v68 offset:0
  ds_read_b32 v72, v72 offset:0
  ds_read_b32 v76, v76 offset:0
  ds_read_b32 v80, v80 offset:0
  ds_read_b32 v84, v84 offset:0
  ds_read_b32 v88, v88 offset:0
  ds_read_b32 v92, v92 offset:0
  v_lshlrev_b32 v65, 2, v65
  v_lshlrev_b32 v69, 2, v69
  v_lshlrev_b32 v73, 2, v73
  v_lshlrev_b32 v77, 2, v77
  v_lshlrev_b32 v81, 2, v81
  v_lshlrev_b32 v85, 2, v85
  v_lshlrev_b32 v89, 2, v89
  v_lshlrev_b32 v93, 2, v93
  ds_read_b32 v65, v65 offset:0
  ds_read_b32 v69, v69 offset:0
  ds_read_b32 v73, v73 offset:0
  ds_read_b32 v77, v77 offset:0
  ds_read_b32 v81, v81 offset:0
  ds_read_b32 v85, v85 offset:0
  ds_read_b32 v89, v89 offset:0
  ds_read_b32 v93, v93 offset:0
  s_waitcnt lgkmcnt(8)
  v_lshlrev_b32 v48, 16, v96
  v_mul_f32 v64, v48, v64
  v_mul_f32 v68, v48, v68
  v_mul_f32 v72, v48, v72
  v_mul_f32 v76, v48, v76
  v_mul_f32 v80, v48, v80
  v_mul_f32 v84, v48, v84
  v_mul_f32 v88, v48, v88
  v_mul_f32 v92, v48, v92
  v_cvt_pk_bf16_f32 v32, v64, v68
  v_cvt_pk_bf16_f32 v33, v72, v76
  v_cvt_pk_bf16_f32 v34, v80, v84
  v_cvt_pk_bf16_f32 v35, v88, v92
  ds_write_b128 v25, v[32:35] offset:0
  v_lshlrev_b32 v66, 2, v66
  v_lshlrev_b32 v70, 2, v70
  v_lshlrev_b32 v74, 2, v74
  v_lshlrev_b32 v78, 2, v78
  v_lshlrev_b32 v82, 2, v82
  v_lshlrev_b32 v86, 2, v86
  v_lshlrev_b32 v90, 2, v90
  v_lshlrev_b32 v94, 2, v94
  ds_read_b32 v66, v66 offset:0
  ds_read_b32 v70, v70 offset:0
  ds_read_b32 v74, v74 offset:0
  ds_read_b32 v78, v78 offset:0
  ds_read_b32 v82, v82 offset:0
  ds_read_b32 v86, v86 offset:0
  ds_read_b32 v90, v90 offset:0
  ds_read_b32 v94, v94 offset:0
  s_waitcnt lgkmcnt(9)
  v_and_b32 v48, 0xffff0000, v96
  v_mul_f32 v65, v48, v65
  v_mul_f32 v69, v48, v69
  v_mul_f32 v73, v48, v73
  v_mul_f32 v77, v48, v77
  v_mul_f32 v81, v48, v81
  v_mul_f32 v85, v48, v85
  v_mul_f32 v89, v48, v89
  v_mul_f32 v93, v48, v93
  v_cvt_pk_bf16_f32 v36, v65, v69
  v_cvt_pk_bf16_f32 v37, v73, v77
  v_cvt_pk_bf16_f32 v38, v81, v85
  v_cvt_pk_bf16_f32 v39, v89, v93
  ds_write_b128 v25, v[36:39] offset:1024
  v_lshlrev_b32 v67, 2, v67
  v_lshlrev_b32 v71, 2, v71
  v_lshlrev_b32 v75, 2, v75
  v_lshlrev_b32 v79, 2, v79
  v_lshlrev_b32 v83, 2, v83
  v_lshlrev_b32 v87, 2, v87
  v_lshlrev_b32 v91, 2, v91
  v_lshlrev_b32 v95, 2, v95
  ds_read_b32 v67, v67 offset:0
  ds_read_b32 v71, v71 offset:0
  ds_read_b32 v75, v75 offset:0
  ds_read_b32 v79, v79 offset:0
  ds_read_b32 v83, v83 offset:0
  ds_read_b32 v87, v87 offset:0
  ds_read_b32 v91, v91 offset:0
  ds_read_b32 v95, v95 offset:0
  s_waitcnt lgkmcnt(9)
  v_lshlrev_b32 v48, 16, v97
  v_mul_f32 v66, v48, v66
  v_mul_f32 v70, v48, v70
  v_mul_f32 v74, v48, v74
  v_mul_f32 v78, v48, v78
  v_mul_f32 v82, v48, v82
  v_mul_f32 v86, v48, v86
  v_mul_f32 v90, v48, v90
  v_mul_f32 v94, v48, v94
  v_cvt_pk_bf16_f32 v40, v66, v70
  v_cvt_pk_bf16_f32 v41, v74, v78
  v_cvt_pk_bf16_f32 v42, v82, v86
  v_cvt_pk_bf16_f32 v43, v90, v94
  ds_write_b128 v25, v[40:43] offset:2048
  s_waitcnt lgkmcnt(1)
  v_and_b32 v48, 0xffff0000, v97
  v_mul_f32 v67, v48, v67
  v_mul_f32 v71, v48, v71
  v_mul_f32 v75, v48, v75
  v_mul_f32 v79, v48, v79
  v_mul_f32 v83, v48, v83
  v_mul_f32 v87, v48, v87
  v_mul_f32 v91, v48, v91
  v_mul_f32 v95, v48, v95
  v_cvt_pk_bf16_f32 v44, v67, v71
  v_cvt_pk_bf16_f32 v45, v75, v79
  v_cvt_pk_bf16_f32 v46, v83, v87
  v_cvt_pk_bf16_f32 v47, v91, v95
  ds_write_b128 v25, v[44:47] offset:3072
  buffer_store_dwordx4 v[32:35], v26, s[84:87], s46 offen offset:0 sc0 sc1
  buffer_store_dwordx4 v[36:39], v26, s[84:87], s46 offen offset:1024 sc0 sc1
  buffer_store_dwordx4 v[40:43], v26, s[84:87], s46 offen offset:2048 sc0 sc1
  buffer_store_dwordx4 v[44:47], v26, s[84:87], s46 offen offset:3072 sc0 sc1
  s_bfe_u32 s54, s70, 0x40004
  s_bfe_u32 s55, s70, 0x40008
  s_waitcnt lgkmcnt(0)
  s_barrier
  s_lshl_b32 s98, 1, s91
  s_mov_b32 s99, 0
  s_waitcnt vmcnt(0)
  s_mov_b64 exec, 1
  buffer_store_dwordx2 v[30:31], v28, s[92:95], s47 offen sc0 sc1
  s_mov_b64 exec, -1
  s_setprio 0
  s_lshl_b32 s53, s54, 7
  s_add_u32 m0, s56, 49152
  s_nop 0
  buffer_load_dwordx4 v2, s[4:7], s53 offen offset:0 lds
  buffer_load_dwordx4 v3, s[4:7], s53 offen offset:1024 lds
  buffer_load_dwordx4 v4, s[4:7], s53 offen offset:2048 lds
  buffer_load_dwordx4 v5, s[4:7], s53 offen offset:3072 lds
  s_add_u32 m0, s56, 53248
  s_nop 0
  buffer_load_dwordx4 v6, s[4:7], s53 offen offset:0 lds
  buffer_load_dwordx4 v7, s[4:7], s53 offen offset:1024 lds
  buffer_load_dwordx4 v8, s[4:7], s53 offen offset:2048 lds
  buffer_load_dwordx4 v9, s[4:7], s53 offen offset:3072 lds
L_f1:
  s_bitcmp1_b32 s98, s54
  s_cbranch_scc1 L_fok1
  buffer_load_dwordx2 v[50:51], v29, s[92:95], s74 offen sc1
  s_waitcnt vmcnt(0)
  v_cmp_eq_u64 vcc, s[96:97], v[50:51]
  s_add_u32 s99, s99, 1
  s_or_b32 s98, s98, vcc_lo
  s_cmp_lt_u32 s99, 20000
  s_cbranch_scc1 L_f1
L_fok1:
  s_lshl_b32 s53, s54, 14
  s_add_u32 m0, s58, 49152
  s_add_u32 s53, s53, s73
  buffer_load_dwordx4 v26, s[84:87], s53 offen offset:0 sc1 lds
  buffer_load_dwordx4 v26, s[84:87], s53 offen offset:1024 sc1 lds
  buffer_load_dwordx4 v26, s[84:87], s53 offen offset:2048 sc1 lds
  buffer_load_dwordx4 v26, s[84:87], s53 offen offset:3072 sc1 lds
L_f2:
  s_bitcmp1_b32 s98, s55
  s_cbranch_scc1 L_fok2
  buffer_load_dwordx2 v[50:51], v29, s[92:95], s74 offen sc1
  s_waitcnt vmcnt(0)
  v_cmp_eq_u64 vcc, s[96:97], v[50:51]
  s_add_u32 s99, s99, 1
  s_or_b32 s98, s98, vcc_lo
  s_cmp_lt_u32 s99, 20000
  s_cbranch_scc1 L_f2
L_fok2:
  s_lshl_b32 s53, s55, 14
  s_add_u32 m0, s58, 98304
  s_add_u32 s53, s53, s73
  buffer_load_dwordx4 v26, s[84:87], s53 offen offset:0 sc1 lds
  buffer_load_dwordx4 v26, s[84:87], s53 offen offset:1024 sc1 lds
  buffer_load_dwordx4 v26, s[84:87], s53 offen offset:2048 sc1 lds
  buffer_load_dwordx4 v26, s[84:87], s53 offen offset:3072 sc1 lds
  s_lshl_b32 s53, s55, 7
  s_add_u32 m0, s56, 98304
  s_nop 0
  buffer_load_dwordx4 v2, s[4:7], s53 offen offset:0 lds
  buffer_load_dwordx4 v3, s[4:7], s53 offen offset:1024 lds
  buffer_load_dwordx4 v4, s[4:7], s53 offen offset:2048 lds
  buffer_load_dwordx4 v5, s[4:7], s53 offen offset:3072 lds
  s_add_u32 m0, s56, 102400
  s_nop 0
  buffer_load_dwordx4 v6, s[4:7], s53 offen offset:0 lds
  buffer_load_dwordx4 v7, s[4:7], s53 offen offset:1024 lds
  buffer_load_dwordx4 v8, s[4:7], s53 offen offset:2048 lds
  buffer_load_dwordx4 v9, s[4:7], s53 offen offset:3072 lds
  s_mov_b32 s59, 3
  s_mov_b32 s55, 0
  s_mov_b32 s100, 0xffff
  s_waitcnt vmcnt(12)
L_lloop:
  s_cmp_eq_u32 s100, 0xffff
  s_cbranch_scc1 L_noev
  v_cmp_eq_u64 vcc, s[96:97], v[50:51]
  s_add_u32 s99, s99, 1
  s_or_b32 s98, s98, vcc_lo
L_noev:
  s_lshl_b32 s50, s59, 2
  s_lshr_b64 s[50:51], s[70:71], s50
  s_and_b32 s54, s50, 15
  s_lshl_b32 s53, s54, 7
  s_add_u32 s52, s56, s55
  s_bfe_u32 s51, s50, 0x40004
  s_bfe_u32 s50, s50, 0x40008
  s_lshl_b32 s50, 1, s50
  s_bitset1_b32 s50, s51
  s_bitset1_b32 s50, s54
  s_and_b32 s100, s98, s50
  s_cmp_eq_u32 s100, s50
  s_mov_b32 s100, 0xffff
  s_cbranch_scc1 L_nopoll
  s_mov_b32 s100, 0
  buffer_load_dwordx2 v[50:51], v29, s[92:95], s74 offen sc1
L_nopoll:
  s_mov_b32 m0, s52
  s_barrier
  buffer_load_dwordx4 v2, s[4:7], s53 offen offset:0 lds
  buffer_load_dwordx4 v3, s[4:7], s53 offen offset:1024 lds
  buffer_load_dwordx4 v4, s[4:7], s53 offen offset:2048 lds
  buffer_load_dwordx4 v5, s[4:7], s53 offen offset:3072 lds
  s_add_u32 m0, s52, 4096
  s_nop 0
  buffer_load_dwordx4 v6, s[4:7], s53 offen offset:0 lds
  buffer_load_dwordx4 v7, s[4:7], s53 offen offset:1024 lds
  buffer_load_dwordx4 v8, s[4:7], s53 offen offset:2048 lds
  buffer_load_dwordx4 v9, s[4:7], s53 offen offset:3072 lds
  s_bitcmp1_b32 s98, s54
  s_cbranch_scc1 L_rdy2
  s_waitcnt vmcnt(8)
  v_cmp_eq_u64 vcc, s[96:97], v[50:51]
  s_add_u32 s99, s99, 1
  s_or_b32 s98, s98, vcc_lo
L_chk:
  s_mov_b32 s100, 0xffff
  s_bitcmp1_b32 s98, s54
  s_cbranch_scc1 L_rdy2
  buffer_load_dwordx2 v[50:51], v29, s[92:95], s74 offen sc1
  s_waitcnt vmcnt(0)
  v_cmp_eq_u64 vcc, s[96:97], v[50:51]
  s_add_u32 s99, s99, 1
  s_or_b32 s98, s98, vcc_lo
  s_cmp_lt_u32 s99, 20000
  s_cbranch_scc1 L_chk
L_rdy2:
  s_lshl_b32 s53, s54, 14
  s_add_u32 m0, s58, s55
  s_add_u32 s53, s53, s73
  buffer_load_dwordx4 v26, s[84:87], s53 offen offset:0 sc1 lds
  buffer_load_dwordx4 v26, s[84:87], s53 offen offset:1024 sc1 lds
  buffer_load_dwordx4 v26, s[84:87], s53 offen offset:2048 sc1 lds
  buffer_load_dwordx4 v26, s[84:87], s53 offen offset:3072 sc1 lds
  s_add_u32 s55, s55, 49152
  s_cmp_eq_u32 s55, 147456
  s_cselect_b32 s55, 0, s55
  s_add_u32 s59, s59, 1
  s_cmp_lt_u32 s59, 16
  s_waitcnt vmcnt(12)
  s_cbranch_scc1 L_lloop
  s_barrier
  s_waitcnt vmcnt(0)
  s_barrier
  s_cmp_lg_u32 s88, 0
  s_cbranch_scc1 L_nog
  s_mov_b64 exec, 1
  v_mov_b32 v29, s75
  global_store_dwordx2 v29, v[30:31], s[60:61] sc0 sc1
  s_mov_b64 exec, -1
L_nog:
  s_endpgm
L_help:
  s_add_u32 s40, s40, 128
  s_mul_i32 s41, s40, 9363
  s_lshr_b32 s41, s41, 20
  s_mul_i32 s42, s41, 112
  s_sub_u32 s42, s40, s42
  s_lshr_b32 s38, s42, 2
  s_and_b32 s37, s42, 3
  s_lshl_b32 s43, s41, 2
  s_add_u32 s43, s43, s37
  s_mul_i32 s50, s43, 229376
  s_lshl_b32 s37, s38, 9
  s_add_u32 s50, s50, s37
  s_lshr_b32 s51, s43, 1
  s_mul_i32 s51, s51, 7168
  s_lshl_b32 s37, s38, 8
  s_add_u32 s51, s51, s37
  s_lshl_b32 s52, s43, 12
  s_lshl_b32 s37, s38, 18
  s_add_u32 s52, s52, s37
  s_lshl_b32 s53, s42, 7
  s_lshl_b32 s37, s41, 3
  s_add_u32 s53, s53, s37
  s_lshl_b32 s43, s42, 7
  s_add_u32 s43, s43, 0x50000
  s_cmp_lt_u32 s40, 1792
  s_cselect_b32 s10, s10, 0
  s_cselect_b32 s14, s14, 0
  buffer_load_dwordx2 v[132:133], v24, s[12:15], s51 offen
  buffer_load_dwordx4 v[100:103], v16, s[8:11], s50 offen
  buffer_load_dwordx4 v[104:107], v17, s[8:11], s50 offen
  buffer_load_dwordx4 v[108:111], v18, s[8:11], s50 offen
  buffer_load_dwordx4 v[112:115], v19, s[8:11], s50 offen
  buffer_load_dwordx4 v[116:119], v20, s[8:11], s50 offen
  buffer_load_dwordx4 v[120:123], v21, s[8:11], s50 offen
  buffer_load_dwordx4 v[124:127], v22, s[8:11], s50 offen
  buffer_load_dwordx4 v[128:131], v23, s[8:11], s50 offen
  s_load_dwordx2 s[54:55], s[60:61], s43
  v_lshlrev_b32 v30, 2, v0
  s_waitcnt vmcnt(18)
  v_lshlrev_b32 v31, 16, v31
  ds_write_b32 v30, v31 offset:0
  s_waitcnt lgkmcnt(0)
  s_add_u32 s40, s40, 128
  s_mov_b32 s59, 0
  s_waitcnt vmcnt(9)
L_hloop:
  s_cmp_ge_u32 s40, 2048
  s_cbranch_scc1 L_hdone
  s_waitcnt vmcnt(13) lgkmcnt(0)
  v_lshlrev_b32 v64, 2, v64
  v_lshlrev_b32 v68, 2, v68
  v_lshlrev_b32 v72, 2, v72
  v_lshlrev_b32 v76, 2, v76
  v_lshlrev_b32 v80, 2, v80
  v_lshlrev_b32 v84, 2, v84
  v_lshlrev_b32 v88, 2, v88
  v_lshlrev_b32 v92, 2, v92
  ds_read_b32 v64, v64 offset:0
  ds_read_b32 v68, v68 offset:0
  ds_read_b32 v72, v72 offset:0
  ds_read_b32 v76, v76 offset:0
  ds_read_b32 v80, v80 offset:0
  ds_read_b32 v84, v84 offset:0
  ds_read_b32 v88, v88 offset:0
  ds_read_b32 v92, v92 offset:0
  v_lshlrev_b32 v65, 2, v65
  v_lshlrev_b32 v69, 2, v69
  v_lshlrev_b32 v73, 2, v73
  v_lshlrev_b32 v77, 2, v77
  v_lshlrev_b32 v81, 2, v81
  v_lshlrev_b32 v85, 2, v85
  v_lshlrev_b32 v89, 2, v89
  v_lshlrev_b32 v93, 2, v93
  ds_read_b32 v65, v65 offset:0
  ds_read_b32 v69, v69 offset:0
  ds_read_b32 v73, v73 offset:0
  ds_read_b32 v77, v77 offset:0
  ds_read_b32 v81, v81 offset:0
  ds_read_b32 v85, v85 offset:0
  ds_read_b32 v89, v89 offset:0
  ds_read_b32 v93, v93 offset:0
  s_waitcnt lgkmcnt(8)
  v_lshlrev_b32 v48, 16, v96
  v_mul_f32 v64, v48, v64
  v_mul_f32 v68, v48, v68
  v_mul_f32 v72, v48, v72
  v_mul_f32 v76, v48, v76
  v_mul_f32 v80, v48, v80
  v_mul_f32 v84, v48, v84
  v_mul_f32 v88, v48, v88
  v_mul_f32 v92, v48, v92
  v_cvt_pk_bf16_f32 v32, v64, v68
  v_cvt_pk_bf16_f32 v33, v72, v76
  v_cvt_pk_bf16_f32 v34, v80, v84
  v_cvt_pk_bf16_f32 v35, v88, v92
  buffer_store_dwordx4 v[32:35], v26, s[84:87], s46 offen offset:0 sc0 sc1
  v_lshlrev_b32 v66, 2, v66
  v_lshlrev_b32 v70, 2, v70
  v_lshlrev_b32 v74, 2, v74
  v_lshlrev_b32 v78, 2, v78
  v_lshlrev_b32 v82, 2, v82
  v_lshlrev_b32 v86, 2, v86
  v_lshlrev_b32 v90, 2, v90
  v_lshlrev_b32 v94, 2, v94
  ds_read_b32 v66, v66 offset:0
  ds_read_b32 v70, v70 offset:0
  ds_read_b32 v74, v74 offset:0
  ds_read_b32 v78, v78 offset:0
  ds_read_b32 v82, v82 offset:0
  ds_read_b32 v86, v86 offset:0
  ds_read_b32 v90, v90 offset:0
  ds_read_b32 v94, v94 offset:0
  s_waitcnt lgkmcnt(8)
  v_and_b32 v48, 0xffff0000, v96
  v_mul_f32 v65, v48, v65
  v_mul_f32 v69, v48, v69
  v_mul_f32 v73, v48, v73
  v_mul_f32 v77, v48, v77
  v_mul_f32 v81, v48, v81
  v_mul_f32 v85, v48, v85
  v_mul_f32 v89, v48, v89
  v_mul_f32 v93, v48, v93
  v_cvt_pk_bf16_f32 v36, v65, v69
  v_cvt_pk_bf16_f32 v37, v73, v77
  v_cvt_pk_bf16_f32 v38, v81, v85
  v_cvt_pk_bf16_f32 v39, v89, v93
  s_waitcnt vmcnt(10)
  s_cmp_eq_u32 s59, 0
  s_cbranch_scc1 L_hnf0
  s_mov_b64 exec, 1
  buffer_store_dwordx2 v[50:51], v28, s[92:95], s58 offen sc0 sc1
  s_mov_b64 exec, -1
L_hnf0:
  buffer_store_dwordx4 v[36:39], v26, s[84:87], s46 offen offset:1024 sc0 sc1
  v_lshlrev_b32 v67, 2, v67
  v_lshlrev_b32 v71, 2, v71
  v_lshlrev_b32 v75, 2, v75
  v_lshlrev_b32 v79, 2, v79
  v_lshlrev_b32 v83, 2, v83
  v_lshlrev_b32 v87, 2, v87
  v_lshlrev_b32 v91, 2, v91
  v_lshlrev_b32 v95, 2, v95
  ds_read_b32 v67, v67 offset:0
  ds_read_b32 v71, v71 offset:0
  ds_read_b32 v75, v75 offset:0
  ds_read_b32 v79, v79 offset:0
  ds_read_b32 v83, v83 offset:0
  ds_read_b32 v87, v87 offset:0
  ds_read_b32 v91, v91 offset:0
  ds_read_b32 v95, v95 offset:0
  s_waitcnt lgkmcnt(8)
  v_lshlrev_b32 v48, 16, v97
  v_mul_f32 v66, v48, v66
  v_mul_f32 v70, v48, v70
  v_mul_f32 v74, v48, v74
  v_mul_f32 v78, v48, v78
  v_mul_f32 v82, v48, v82
  v_mul_f32 v86, v48, v86
  v_mul_f32 v90, v48, v90
  v_mul_f32 v94, v48, v94
  v_cvt_pk_bf16_f32 v40, v66, v70
  v_cvt_pk_bf16_f32 v41, v74, v78
  v_cvt_pk_bf16_f32 v42, v82, v86
  v_cvt_pk_bf16_f32 v43, v90, v94
  buffer_store_dwordx4 v[40:43], v26, s[84:87], s46 offen offset:2048 sc0 sc1
  s_waitcnt lgkmcnt(0)
  v_and_b32 v48, 0xffff0000, v97
  v_mul_f32 v67, v48, v67
  v_mul_f32 v71, v48, v71
  v_mul_f32 v75, v48, v75
  v_mul_f32 v79, v48, v79
  v_mul_f32 v83, v48, v83
  v_mul_f32 v87, v48, v87
  v_mul_f32 v91, v48, v91
  v_mul_f32 v95, v48, v95
  v_cvt_pk_bf16_f32 v44, v67, v71
  v_cvt_pk_bf16_f32 v45, v75, v79
  v_cvt_pk_bf16_f32 v46, v83, v87
  v_cvt_pk_bf16_f32 v47, v91, v95
  buffer_store_dwordx4 v[44:47], v26, s[84:87], s46 offen offset:3072 sc0 sc1
  s_add_u32 s48, s48, 0x9e3779b9
  s_add_u32 s49, s49, 0x7feb352d
  v_mov_b32 v50, s48
  v_mov_b32 v51, s49
  s_mov_b32 s58, s47
  s_mov_b32 s59, 1
  s_mul_i32 s41, s40, 9363
  s_lshr_b32 s41, s41, 20
  s_mul_i32 s42, s41, 112
  s_sub_u32 s42, s40, s42
  s_lshr_b32 s38, s42, 2
  s_and_b32 s37, s42, 3
  s_lshl_b32 s43, s41, 2
  s_add_u32 s43, s43, s37
  s_mul_i32 s44, s43, 229376
  s_lshl_b32 s37, s38, 9
  s_add_u32 s44, s44, s37
  s_lshr_b32 s45, s43, 1
  s_mul_i32 s45, s45, 7168
  s_lshl_b32 s37, s38, 8
  s_add_u32 s45, s45, s37
  s_lshl_b32 s46, s43, 12
  s_lshl_b32 s37, s38, 18
  s_add_u32 s46, s46, s37
  s_lshl_b32 s47, s42, 7
  s_lshl_b32 s37, s41, 3
  s_add_u32 s47, s47, s37
  s_lshl_b32 s43, s42, 7
  s_add_u32 s43, s43, 0x50000
  s_cmp_lt_u32 s40, 1792
  s_cselect_b32 s10, s10, 0
  s_cselect_b32 s14, s14, 0
  buffer_load_dwordx2 v[96:97], v24, s[12:15], s45 offen
  buffer_load_dwordx4 v[64:67], v16, s[8:11], s44 offen
  buffer_load_dwordx4 v[68:71], v17, s[8:11], s44 offen
  buffer_load_dwordx4 v[72:75], v18, s[8:11], s44 offen
  buffer_load_dwordx4 v[76:79], v19, s[8:11], s44 offen
  buffer_load_dwordx4 v[80:83], v20, s[8:11], s44 offen
  buffer_load_dwordx4 v[84:87], v21, s[8:11], s44 offen
  buffer_load_dwordx4 v[88:91], v22, s[8:11], s44 offen
  buffer_load_dwordx4 v[92:95], v23, s[8:11], s44 offen
  s_load_dwordx2 s[48:49], s[60:61], s43
  s_add_u32 s40, s40, 128
  s_cmp_ge_u32 s40, 2048
  s_cbranch_scc1 L_hdone
  s_waitcnt vmcnt(13) lgkmcnt(0)
  v_lshlrev_b32 v100, 2, v100
  v_lshlrev_b32 v104, 2, v104
  v_lshlrev_b32 v108, 2, v108
  v_lshlrev_b32 v112, 2, v112
  v_lshlrev_b32 v116, 2, v116
  v_lshlrev_b32 v120, 2, v120
  v_lshlrev_b32 v124, 2, v124
  v_lshlrev_b32 v128, 2, v128
  ds_read_b32 v100, v100 offset:0
  ds_read_b32 v104, v104 offset:0
  ds_read_b32 v108, v108 offset:0
  ds_read_b32 v112, v112 offset:0
  ds_read_b32 v116, v116 offset:0
  ds_read_b32 v120, v120 offset:0
  ds_read_b32 v124, v124 offset:0
  ds_read_b32 v128, v128 offset:0
  v_lshlrev_b32 v101, 2, v101
  v_lshlrev_b32 v105, 2, v105
  v_lshlrev_b32 v109, 2, v109
  v_lshlrev_b32 v113, 2, v113
  v_lshlrev_b32 v117, 2, v117
  v_lshlrev_b32 v121, 2, v121
  v_lshlrev_b32 v125, 2, v125
  v_lshlrev_b32 v129, 2, v129
  ds_read_b32 v101, v101 offset:0
  ds_read_b32 v105, v105 offset:0
  ds_read_b32 v109, v109 offset:0
  ds_read_b32 v113, v113 offset:0
  ds_read_b32 v117, v117 offset:0
  ds_read_b32 v121, v121 offset:0
  ds_read_b32 v125, v125 offset:0
  ds_read_b32 v129, v129 offset:0
  s_waitcnt lgkmcnt(8)
  v_lshlrev_b32 v48, 16, v132
  v_mul_f32 v100, v48, v100
  v_mul_f32 v104, v48, v104
  v_mul_f32 v108, v48, v108
  v_mul_f32 v112, v48, v112
  v_mul_f32 v116, v48, v116
  v_mul_f32 v120, v48, v120
  v_mul_f32 v124, v48, v124
  v_mul_f32 v128, v48, v128
  v_cvt_pk_bf16_f32 v32, v100, v104
  v_cvt_pk_bf16_f32 v33, v108, v112
  v_cvt_pk_bf16_f32 v34, v116, v120
  v_cvt_pk_bf16_f32 v35, v124, v128
  buffer_store_dwordx4 v[32:35], v26, s[84:87], s52 offen offset:0 sc0 sc1
  v_lshlrev_b32 v102, 2, v102
  v_lshlrev_b32 v106, 2, v106
  v_lshlrev_b32 v110, 2, v110
  v_lshlrev_b32 v114, 2, v114
  v_lshlrev_b32 v118, 2, v118
  v_lshlrev_b32 v122, 2, v122
  v_lshlrev_b32 v126, 2, v126
  v_lshlrev_b32 v130, 2, v130
  ds_read_b32 v102, v102 offset:0
  ds_read_b32 v106, v106 offset:0
  ds_read_b32 v110, v110 offset:0
  ds_read_b32 v114, v114 offset:0
  ds_read_b32 v118, v118 offset:0
  ds_read_b32 v122, v122 offset:0
  ds_read_b32 v126, v126 offset:0
  ds_read_b32 v130, v130 offset:0
  s_waitcnt lgkmcnt(8)
  v_and_b32 v48, 0xffff0000, v132
  v_mul_f32 v101, v48, v101
  v_mul_f32 v105, v48, v105
  v_mul_f32 v109, v48, v109
  v_mul_f32 v113, v48, v113
  v_mul_f32 v117, v48, v117
  v_mul_f32 v121, v48, v121
  v_mul_f32 v125, v48, v125
  v_mul_f32 v129, v48, v129
  v_cvt_pk_bf16_f32 v36, v101, v105
  v_cvt_pk_bf16_f32 v37, v109, v113
  v_cvt_pk_bf16_f32 v38, v117, v121
  v_cvt_pk_bf16_f32 v39, v125, v129
  s_waitcnt vmcnt(10)
  s_cmp_eq_u32 s59, 0
  s_cbranch_scc1 L_hnf1
  s_mov_b64 exec, 1
  buffer_store_dwordx2 v[50:51], v28, s[92:95], s58 offen sc0 sc1
  s_mov_b64 exec, -1
L_hnf1:
  buffer_store_dwordx4 v[36:39], v26, s[84:87], s52 offen offset:1024 sc0 sc1
  v_lshlrev_b32 v103, 2, v103
  v_lshlrev_b32 v107, 2, v107
  v_lshlrev_b32 v111, 2, v111
  v_lshlrev_b32 v115, 2, v115
  v_lshlrev_b32 v119, 2, v119
  v_lshlrev_b32 v123, 2, v123
  v_lshlrev_b32 v127, 2, v127
  v_lshlrev_b32 v131, 2, v131
  ds_read_b32 v103, v103 offset:0
  ds_read_b32 v107, v107 offset:0
  ds_read_b32 v111, v111 offset:0
  ds_read_b32 v115, v115 offset:0
  ds_read_b32 v119, v119 offset:0
  ds_read_b32 v123, v123 offset:0
  ds_read_b32 v127, v127 offset:0
  ds_read_b32 v131, v131 offset:0
  s_waitcnt lgkmcnt(8)
  v_lshlrev_b32 v48, 16, v133
  v_mul_f32 v102, v48, v102
  v_mul_f32 v106, v48, v106
  v_mul_f32 v110, v48, v110
  v_mul_f32 v114, v48, v114
  v_mul_f32 v118, v48, v118
  v_mul_f32 v122, v48, v122
  v_mul_f32 v126, v48, v126
  v_mul_f32 v130, v48, v130
  v_cvt_pk_bf16_f32 v40, v102, v106
  v_cvt_pk_bf16_f32 v41, v110, v114
  v_cvt_pk_bf16_f32 v42, v118, v122
  v_cvt_pk_bf16_f32 v43, v126, v130
  buffer_store_dwordx4 v[40:43], v26, s[84:87], s52 offen offset:2048 sc0 sc1
  s_waitcnt lgkmcnt(0)
  v_and_b32 v48, 0xffff0000, v133
  v_mul_f32 v103, v48, v103
  v_mul_f32 v107, v48, v107
  v_mul_f32 v111, v48, v111
  v_mul_f32 v115, v48, v115
  v_mul_f32 v119, v48, v119
  v_mul_f32 v123, v48, v123
  v_mul_f32 v127, v48, v127
  v_mul_f32 v131, v48, v131
  v_cvt_pk_bf16_f32 v44, v103, v107
  v_cvt_pk_bf16_f32 v45, v111, v115
  v_cvt_pk_bf16_f32 v46, v119, v123
  v_cvt_pk_bf16_f32 v47, v127, v131
  buffer_store_dwordx4 v[44:47], v26, s[84:87], s52 offen offset:3072 sc0 sc1
  s_add_u32 s54, s54, 0x9e3779b9
  s_add_u32 s55, s55, 0x7feb352d
  v_mov_b32 v50, s54
  v_mov_b32 v51, s55
  s_mov_b32 s58, s53
  s_mov_b32 s59, 1
  s_mul_i32 s41, s40, 9363
  s_lshr_b32 s41, s41, 20
  s_mul_i32 s42, s41, 112
  s_sub_u32 s42, s40, s42
  s_lshr_b32 s38, s42, 2
  s_and_b32 s37, s42, 3
  s_lshl_b32 s43, s41, 2
  s_add_u32 s43, s43, s37
  s_mul_i32 s50, s43, 229376
  s_lshl_b32 s37, s38, 9
  s_add_u32 s50, s50, s37
  s_lshr_b32 s51, s43, 1
  s_mul_i32 s51, s51, 7168
  s_lshl_b32 s37, s38, 8
  s_add_u32 s51, s51, s37
  s_lshl_b32 s52, s43, 12
  s_lshl_b32 s37, s38, 18
  s_add_u32 s52, s52, s37
  s_lshl_b32 s53, s42, 7
  s_lshl_b32 s37, s41, 3
  s_add_u32 s53, s53, s37
  s_lshl_b32 s43, s42, 7
  s_add_u32 s43, s43, 0x50000
  s_cmp_lt_u32 s40, 1792
  s_cselect_b32 s10, s10, 0
  s_cselect_b32 s14, s14, 0
  buffer_load_dwordx2 v[132:133], v24, s[12:15], s51 offen
  buffer_load_dwordx4 v[100:103], v16, s[8:11], s50 offen
  buffer_load_dwordx4 v[104:107], v17, s[8:11], s50 offen
  buffer_load_dwordx4 v[108:111], v18, s[8:11], s50 offen
  buffer_load_dwordx4 v[112:115], v19, s[8:11], s50 offen
  buffer_load_dwordx4 v[116:119], v20, s[8:11], s50 offen
  buffer_load_dwordx4 v[120:123], v21, s[8:11], s50 offen
  buffer_load_dwordx4 v[124:127], v22, s[8:11], s50 offen
  buffer_load_dwordx4 v[128:131], v23, s[8:11], s50 offen
  s_load_dwordx2 s[54:55], s[60:61], s43
  s_add_u32 s40, s40, 128
  s_branch L_hloop
L_hdone:
  s_waitcnt vmcnt(0) lgkmcnt(0)
  s_mov_b64 exec, 1
  buffer_store_dwordx2 v[50:51], v28, s[92:95], s58 offen sc0 sc1
  s_mov_b64 exec, -1
  s_endpgm
L_mfma:
  s_cmp_lt_u32 s36, 4
  s_cbranch_scc1 L_end
  v_lshrrev_b32 v12, 3, v0
  v_lshlrev_b32 v12, 11, v12
  v_lshrrev_b32 v13, 4, v0
  v_and_b32 v14, 7, v0
  v_xor_b32 v13, v13, v14
  v_lshl_add_u32 v12, v13, 4, v12
  s_lshl_b32 s50, s88, 2
  s_add_u32 s50, s50, s57
  s_lshl_b32 s50, s50, 17
  v_add_u32 v12, s50, v12
  v_xor_b32 v13, 64, v12
  v_add_u32 v2, 0x0, v12
  v_add_u32 v3, 0x3c00, v13
  v_add_u32 v4, 0x7800, v12
  v_add_u32 v5, 0xb400, v13
  v_add_u32 v6, 0x10000, v12
  v_add_u32 v7, 0x13c00, v13
  v_add_u32 v8, 0x17800, v12
  v_add_u32 v9, 0x1b400, v13
  s_lshl_b32 s54, s91, 7
  s_barrier
  s_add_u32 m0, s56, 0
  s_nop 0
  buffer_load_dwordx4 v2, s[4:7], s54 offen offset:0 lds
  buffer_load_dwordx4 v3, s[4:7], s54 offen offset:1024 lds
  buffer_load_dwordx4 v4, s[4:7], s54 offen offset:2048 lds
  buffer_load_dwordx4 v5, s[4:7], s54 offen offset:3072 lds
  s_add_u32 m0, s56, 4096
  s_nop 0
  buffer_load_dwordx4 v6, s[4:7], s54 offen offset:0 lds
  buffer_load_dwordx4 v7, s[4:7], s54 offen offset:1024 lds
  buffer_load_dwordx4 v8, s[4:7], s54 offen offset:2048 lds
  buffer_load_dwordx4 v9, s[4:7], s54 offen offset:3072 lds
  v_mov_b32 v128, 0
  v_mov_b32 v129, 0
  v_mov_b32 v130, 0
  v_mov_b32 v131, 0
  v_mov_b32 v132, 0
  v_mov_b32 v133, 0
  v_mov_b32 v134, 0
  v_mov_b32 v135, 0
  v_mov_b32 v136, 0
  v_mov_b32 v137, 0
  v_mov_b32 v138, 0
  v_mov_b32 v139, 0
  v_mov_b32 v140, 0
  v_mov_b32 v141, 0
  v_mov_b32 v142, 0
  v_mov_b32 v143, 0
  v_mov_b32 v144, 0
  v_mov_b32 v145, 0
  v_mov_b32 v146, 0
  v_mov_b32 v147, 0
  v_mov_b32 v148, 0
  v_mov_b32 v149, 0
  v_mov_b32 v150, 0
  v_mov_b32 v151, 0
  v_mov_b32 v152, 0
  v_mov_b32 v153, 0
  v_mov_b32 v154, 0
  v_mov_b32 v155, 0
  v_mov_b32 v156, 0
  v_mov_b32 v157, 0
  v_mov_b32 v158, 0
  v_mov_b32 v159, 0
  v_mov_b32 v160, 0
  v_mov_b32 v161, 0
  v_mov_b32 v162, 0
  v_mov_b32 v163, 0
  v_mov_b32 v164, 0
  v_mov_b32 v165, 0
  v_mov_b32 v166, 0
  v_mov_b32 v167, 0
  v_mov_b32 v168, 0
  v_mov_b32 v169, 0
  v_mov_b32 v170, 0
  v_mov_b32 v171, 0
  v_mov_b32 v172, 0
  v_mov_b32 v173, 0
  v_mov_b32 v174, 0
  v_mov_b32 v175, 0
  v_mov_b32 v176, 0
  v_mov_b32 v177, 0
  v_mov_b32 v178, 0
  v_mov_b32 v179, 0
  v_mov_b32 v180, 0
  v_mov_b32 v181, 0
  v_mov_b32 v182, 0
  v_mov_b32 v183, 0
  v_mov_b32 v184, 0
  v_mov_b32 v185, 0
  v_mov_b32 v186, 0
  v_mov_b32 v187, 0
  v_mov_b32 v188, 0
  v_mov_b32 v189, 0
  v_mov_b32 v190, 0
  v_mov_b32 v191, 0
  v_mov_b32 v192, 0
  v_mov_b32 v193, 0
  v_mov_b32 v194, 0
  v_mov_b32 v195, 0
  v_mov_b32 v196, 0
  v_mov_b32 v197, 0
  v_mov_b32 v198, 0
  v_mov_b32 v199, 0
  v_mov_b32 v200, 0
  v_mov_b32 v201, 0
  v_mov_b32 v202, 0
  v_mov_b32 v203, 0
  v_mov_b32 v204, 0
  v_mov_b32 v205, 0
  v_mov_b32 v206, 0
  v_mov_b32 v207, 0
  v_mov_b32 v208, 0
  v_mov_b32 v209, 0
  v_mov_b32 v210, 0
  v_mov_b32 v211, 0
  v_mov_b32 v212, 0
  v_mov_b32 v213, 0
  v_mov_b32 v214, 0
  v_mov_b32 v215, 0
  v_mov_b32 v216, 0
  v_mov_b32 v217, 0
  v_mov_b32 v218, 0
  v_mov_b32 v219, 0
  v_mov_b32 v220, 0
  v_mov_b32 v221, 0
  v_mov_b32 v222, 0
  v_mov_b32 v223, 0
  v_mov_b32 v224, 0
  v_mov_b32 v225, 0
  v_mov_b32 v226, 0
  v_mov_b32 v227, 0
  v_mov_b32 v228, 0
  v_mov_b32 v229, 0
  v_mov_b32 v230, 0
  v_mov_b32 v231, 0
  v_mov_b32 v232, 0
  v_mov_b32 v233, 0
  v_mov_b32 v234, 0
  v_mov_b32 v235, 0
  v_mov_b32 v236, 0
  v_mov_b32 v237, 0
  v_mov_b32 v238, 0
  v_mov_b32 v239, 0
  v_mov_b32 v240, 0
  v_mov_b32 v241, 0
  v_mov_b32 v242, 0
  v_mov_b32 v243, 0
  v_mov_b32 v244, 0
  v_mov_b32 v245, 0
  v_mov_b32 v246, 0
  v_mov_b32 v247, 0
  v_mov_b32 v248, 0
  v_mov_b32 v249, 0
  v_mov_b32 v250, 0
  v_mov_b32 v251, 0
  v_mov_b32 v252, 0
  v_mov_b32 v253, 0
  v_mov_b32 v254, 0
  v_mov_b32 v255, 0
  v_and_b32 v24, 15, v0
  v_lshrrev_b32 v25, 4, v0
  v_lshrrev_b32 v29, 1, v24
  v_xor_b32 v29, v29, v25
  v_lshlrev_b32 v29, 4, v29
  v_lshl_add_u32 v29, v24, 7, v29
  v_add_u32 v10, s56, v29
  v_xor_b32 v11, 64, v10
  v_lshrrev_b32 v29, 1, v25
  v_lshlrev_b32 v29, 12, v29
  v_lshl_add_u32 v29, v24, 4, v29
  v_and_b32 v25, 1, v25
  v_lshl_add_u32 v29, v25, 9, v29
  v_add_u32 v12, 33024, v29
  s_mov_b32 s51, 0
  s_mov_b32 s52, 0
  s_setprio 2
  s_barrier
  s_waitcnt vmcnt(0)
  ds_read_b128 v[32:35], v10 offset:0
  ds_read_b128 v[48:51], v12 offset:0
  ds_read_b128 v[36:39], v10 offset:2048
  ds_read_b128 v[40:43], v10 offset:4096
  ds_read_b128 v[44:47], v10 offset:6144
  ds_read_b128 v[52:55], v12 offset:256
  ds_read_b128 v[56:59], v12 offset:1024
  ds_read_b128 v[60:63], v12 offset:1280
  ds_read_b128 v[64:67], v12 offset:2048
  ds_read_b128 v[68:71], v12 offset:2304
  ds_read_b128 v[72:75], v12 offset:3072
  ds_read_b128 v[76:79], v12 offset:3328
  .p2align 6
L_cloop:
  s_waitcnt lgkmcnt(0)
  v_mfma_f32_16x16x32_bf16 v[128:131], v[32:35], v[48:51], v[128:131]
  ds_read_b128 v[80:83], v11 offset:0
  v_mfma_f32_16x16x32_bf16 v[160:163], v[36:39], v[48:51], v[160:163]
  s_add_u32 s51, s51, 1
  v_mfma_f32_16x16x32_bf16 v[192:195], v[40:43], v[48:51], v[192:195]
  ds_read_b128 v[96:99], v12 offset:8192
  v_mfma_f32_16x16x32_bf16 v[224:227], v[44:47], v[48:51], v[224:227]
  s_cmp_eq_u32 s51, 3
  v_mfma_f32_16x16x32_bf16 v[132:135], v[32:35], v[52:55], v[132:135]
  ds_read_b128 v[84:87], v11 offset:2048
  v_mfma_f32_16x16x32_bf16 v[164:167], v[36:39], v[52:55], v[164:167]
  s_cselect_b32 s51, 0, s51
  v_mfma_f32_16x16x32_bf16 v[196:199], v[40:43], v[52:55], v[196:199]
  ds_read_b128 v[88:91], v11 offset:4096
  v_mfma_f32_16x16x32_bf16 v[228:231], v[44:47], v[52:55], v[228:231]
  s_mov_b32 s53, 49152
  v_mfma_f32_16x16x32_bf16 v[136:139], v[32:35], v[56:59], v[136:139]
  ds_read_b128 v[92:95], v11 offset:6144
  v_mfma_f32_16x16x32_bf16 v[168:171], v[36:39], v[56:59], v[168:171]
  s_cselect_b32 s53, -98304, s53
  v_mfma_f32_16x16x32_bf16 v[200:203], v[40:43], v[56:59], v[200:203]
  ds_read_b128 v[100:103], v12 offset:8448
  v_mfma_f32_16x16x32_bf16 v[232:235], v[44:47], v[56:59], v[232:235]
  v_mfma_f32_16x16x32_bf16 v[140:143], v[32:35], v[60:63], v[140:143]
  ds_read_b128 v[104:107], v12 offset:9216
  v_mfma_f32_16x16x32_bf16 v[172:175], v[36:39], v[60:63], v[172:175]
  v_mfma_f32_16x16x32_bf16 v[204:207], v[40:43], v[60:63], v[204:207]
  ds_read_b128 v[108:111], v12 offset:9472
  v_mfma_f32_16x16x32_bf16 v[236:239], v[44:47], v[60:63], v[236:239]
  v_mfma_f32_16x16x32_bf16 v[144:147], v[32:35], v[64:67], v[144:147]
  ds_read_b128 v[112:115], v12 offset:10240
  v_mfma_f32_16x16x32_bf16 v[176:179], v[36:39], v[64:67], v[176:179]
  v_mfma_f32_16x16x32_bf16 v[208:211], v[40:43], v[64:67], v[208:211]
  ds_read_b128 v[116:119], v12 offset:10496
  v_mfma_f32_16x16x32_bf16 v[240:243], v[44:47], v[64:67], v[240:243]
  v_mfma_f32_16x16x32_bf16 v[148:151], v[32:35], v[68:71], v[148:151]
  ds_read_b128 v[120:123], v12 offset:11264
  v_mfma_f32_16x16x32_bf16 v[180:183], v[36:39], v[68:71], v[180:183]
  v_mfma_f32_16x16x32_bf16 v[212:215], v[40:43], v[68:71], v[212:215]
  ds_read_b128 v[124:127], v12 offset:11520
  v_mfma_f32_16x16x32_bf16 v[244:247], v[44:47], v[68:71], v[244:247]
  v_add_u32 v10, s53, v10
  v_mfma_f32_16x16x32_bf16 v[152:155], v[32:35], v[72:75], v[152:155]
  v_add_u32 v11, s53, v11
  v_mfma_f32_16x16x32_bf16 v[184:187], v[36:39], v[72:75], v[184:187]
  v_add_u32 v12, s53, v12
  v_mfma_f32_16x16x32_bf16 v[216:219], v[40:43], v[72:75], v[216:219]
  v_mfma_f32_16x16x32_bf16 v[248:251], v[44:47], v[72:75], v[248:251]
  v_mfma_f32_16x16x32_bf16 v[156:159], v[32:35], v[76:79], v[156:159]
  v_mfma_f32_16x16x32_bf16 v[188:191], v[36:39], v[76:79], v[188:191]
  v_mfma_f32_16x16x32_bf16 v[220:223], v[40:43], v[76:79], v[220:223]
  v_mfma_f32_16x16x32_bf16 v[252:255], v[44:47], v[76:79], v[252:255]
  s_waitcnt lgkmcnt(0)
  s_barrier
  v_mfma_f32_16x16x32_bf16 v[128:131], v[80:83], v[96:99], v[128:131]
  ds_read_b128 v[32:35], v10 offset:0
  v_mfma_f32_16x16x32_bf16 v[160:163], v[84:87], v[96:99], v[160:163]
  s_add_u32 s52, s52, 1
  v_mfma_f32_16x16x32_bf16 v[192:195], v[88:91], v[96:99], v[192:195]
  ds_read_b128 v[48:51], v12 offset:0
  v_mfma_f32_16x16x32_bf16 v[224:227], v[92:95], v[96:99], v[224:227]
  s_cmp_lt_u32 s52, 13
  v_mfma_f32_16x16x32_bf16 v[132:135], v[80:83], v[100:103], v[132:135]
  ds_read_b128 v[36:39], v10 offset:2048
  v_mfma_f32_16x16x32_bf16 v[164:167], v[84:87], v[100:103], v[164:167]
  v_mfma_f32_16x16x32_bf16 v[196:199], v[88:91], v[100:103], v[196:199]
  ds_read_b128 v[40:43], v10 offset:4096
  v_mfma_f32_16x16x32_bf16 v[228:231], v[92:95], v[100:103], v[228:231]
  v_mfma_f32_16x16x32_bf16 v[136:139], v[80:83], v[104:107], v[136:139]
  ds_read_b128 v[44:47], v10 offset:6144
  v_mfma_f32_16x16x32_bf16 v[168:171], v[84:87], v[104:107], v[168:171]
  v_mfma_f32_16x16x32_bf16 v[200:203], v[88:91], v[104:107], v[200:203]
  ds_read_b128 v[52:55], v12 offset:256
  v_mfma_f32_16x16x32_bf16 v[232:235], v[92:95], v[104:107], v[232:235]
  v_mfma_f32_16x16x32_bf16 v[140:143], v[80:83], v[108:111], v[140:143]
  ds_read_b128 v[56:59], v12 offset:1024
  v_mfma_f32_16x16x32_bf16 v[172:175], v[84:87], v[108:111], v[172:175]
  v_mfma_f32_16x16x32_bf16 v[204:207], v[88:91], v[108:111], v[204:207]
  ds_read_b128 v[60:63], v12 offset:1280
  v_mfma_f32_16x16x32_bf16 v[236:239], v[92:95], v[108:111], v[236:239]
  v_mfma_f32_16x16x32_bf16 v[144:147], v[80:83], v[112:115], v[144:147]
  ds_read_b128 v[64:67], v12 offset:2048
  v_mfma_f32_16x16x32_bf16 v[176:179], v[84:87], v[112:115], v[176:179]
  v_mfma_f32_16x16x32_bf16 v[208:211], v[88:91], v[112:115], v[208:211]
  ds_read_b128 v[68:71], v12 offset:2304
  v_mfma_f32_16x16x32_bf16 v[240:243], v[92:95], v[112:115], v[240:243]
  v_mfma_f32_16x16x32_bf16 v[148:151], v[80:83], v[116:119], v[148:151]
  ds_read_b128 v[72:75], v12 offset:3072
  v_mfma_f32_16x16x32_bf16 v[180:183], v[84:87], v[116:119], v[180:183]
  v_mfma_f32_16x16x32_bf16 v[212:215], v[88:91], v[116:119], v[212:215]
  ds_read_b128 v[76:79], v12 offset:3328
  v_mfma_f32_16x16x32_bf16 v[244:247], v[92:95], v[116:119], v[244:247]
  v_mfma_f32_16x16x32_bf16 v[152:155], v[80:83], v[120:123], v[152:155]
  v_mfma_f32_16x16x32_bf16 v[184:187], v[84:87], v[120:123], v[184:187]
  v_mfma_f32_16x16x32_bf16 v[216:219], v[88:91], v[120:123], v[216:219]
  v_mfma_f32_16x16x32_bf16 v[248:251], v[92:95], v[120:123], v[248:251]
  v_mfma_f32_16x16x32_bf16 v[156:159], v[80:83], v[124:127], v[156:159]
  v_mfma_f32_16x16x32_bf16 v[188:191], v[84:87], v[124:127], v[188:191]
  v_mfma_f32_16x16x32_bf16 v[220:223], v[88:91], v[124:127], v[220:223]
  v_mfma_f32_16x16x32_bf16 v[252:255], v[92:95], v[124:127], v[252:255]
  s_cbranch_scc1 L_cloop
  v_add_u32 v13, 49152, v10
  v_add_u32 v14, 49152, v11
  v_add_u32 v15, 49152, v12
  v_add_u32 v16, -49152, v10
  v_add_u32 v17, -49152, v11
  v_add_u32 v18, -49152, v12
  s_waitcnt lgkmcnt(0)
  v_mfma_f32_16x16x32_bf16 v[128:131], v[32:35], v[48:51], v[128:131]
  ds_read_b128 v[96:99], v11 offset:0
  v_and_b32 v24, 15, v0
  v_mfma_f32_16x16x32_bf16 v[160:163], v[36:39], v[48:51], v[160:163]
  ds_read_b128 v[112:115], v12 offset:8192
  v_lshrrev_b32 v25, 4, v0
  v_mfma_f32_16x16x32_bf16 v[192:195], v[40:43], v[48:51], v[192:195]
  ds_read_b128 v[100:103], v11 offset:2048
  v_mul_u32_u24 v25, 28672, v25
  v_mfma_f32_16x16x32_bf16 v[224:227], v[44:47], v[48:51], v[224:227]
  ds_read_b128 v[104:107], v11 offset:4096
  v_lshl_add_u32 v24, v24, 3, v25
  v_mfma_f32_16x16x32_bf16 v[136:139], v[32:35], v[56:59], v[136:139]
  ds_read_b128 v[108:111], v11 offset:6144
  s_lshl_b32 s54, s88, 2
  v_mfma_f32_16x16x32_bf16 v[168:171], v[36:39], v[56:59], v[168:171]
  ds_read_b128 v[116:119], v12 offset:9216
  s_add_u32 s54, s54, s57
  v_mfma_f32_16x16x32_bf16 v[200:203], v[40:43], v[56:59], v[200:203]
  ds_read_b128 v[120:123], v12 offset:10240
  s_mul_i32 s54, s54, 458752
  v_mfma_f32_16x16x32_bf16 v[232:235], v[44:47], v[56:59], v[232:235]
  ds_read_b128 v[124:127], v12 offset:11264
  s_lshl_b32 s55, s89, 8
  s_add_u32 s54, s54, s55
  v_mfma_f32_16x16x32_bf16 v[144:147], v[32:35], v[64:67], v[144:147]
  v_mfma_f32_16x16x32_bf16 v[176:179], v[36:39], v[64:67], v[176:179]
  v_mfma_f32_16x16x32_bf16 v[208:211], v[40:43], v[64:67], v[208:211]
  v_mfma_f32_16x16x32_bf16 v[240:243], v[44:47], v[64:67], v[240:243]
  v_mfma_f32_16x16x32_bf16 v[152:155], v[32:35], v[72:75], v[152:155]
  v_mfma_f32_16x16x32_bf16 v[184:187], v[36:39], v[72:75], v[184:187]
  v_mfma_f32_16x16x32_bf16 v[216:219], v[40:43], v[72:75], v[216:219]
  v_mfma_f32_16x16x32_bf16 v[248:251], v[44:47], v[72:75], v[248:251]
  s_waitcnt lgkmcnt(0)
  s_barrier
  v_mfma_f32_16x16x32_bf16 v[128:131], v[96:99], v[112:115], v[128:131]
  ds_read_b128 v[32:35], v13 offset:0
  v_mfma_f32_16x16x32_bf16 v[160:163], v[100:103], v[112:115], v[160:163]
  ds_read_b128 v[48:51], v15 offset:0
  v_mfma_f32_16x16x32_bf16 v[192:195], v[104:107], v[112:115], v[192:195]
  ds_read_b128 v[36:39], v13 offset:2048
  v_mfma_f32_16x16x32_bf16 v[224:227], v[108:111], v[112:115], v[224:227]
  ds_read_b128 v[40:43], v13 offset:4096
  v_mfma_f32_16x16x32_bf16 v[136:139], v[96:99], v[116:119], v[136:139]
  ds_read_b128 v[44:47], v13 offset:6144
  v_mfma_f32_16x16x32_bf16 v[168:171], v[100:103], v[116:119], v[168:171]
  ds_read_b128 v[52:55], v15 offset:1024
  v_mfma_f32_16x16x32_bf16 v[200:203], v[104:107], v[116:119], v[200:203]
  ds_read_b128 v[56:59], v15 offset:2048
  v_mfma_f32_16x16x32_bf16 v[232:235], v[108:111], v[116:119], v[232:235]
  ds_read_b128 v[60:63], v15 offset:3072
  v_mfma_f32_16x16x32_bf16 v[144:147], v[96:99], v[120:123], v[144:147]
  v_mfma_f32_16x16x32_bf16 v[176:179], v[100:103], v[120:123], v[176:179]
  v_mfma_f32_16x16x32_bf16 v[208:211], v[104:107], v[120:123], v[208:211]
  v_mfma_f32_16x16x32_bf16 v[240:243], v[108:111], v[120:123], v[240:243]
  v_mfma_f32_16x16x32_bf16 v[152:155], v[96:99], v[124:127], v[152:155]
  v_mfma_f32_16x16x32_bf16 v[184:187], v[100:103], v[124:127], v[184:187]
  v_mfma_f32_16x16x32_bf16 v[216:219], v[104:107], v[124:127], v[216:219]
  v_mfma_f32_16x16x32_bf16 v[248:251], v[108:111], v[124:127], v[248:251]
  s_waitcnt lgkmcnt(0)
  v_mfma_f32_16x16x32_bf16 v[128:131], v[32:35], v[48:51], v[128:131]
  ds_read_b128 v[96:99], v14 offset:0
  v_mfma_f32_16x16x32_bf16 v[160:163], v[36:39], v[48:51], v[160:163]
  ds_read_b128 v[112:115], v15 offset:8192
  v_mfma_f32_16x16x32_bf16 v[192:195], v[40:43], v[48:51], v[192:195]
  ds_read_b128 v[100:103], v14 offset:2048
  v_mfma_f32_16x16x32_bf16 v[224:227], v[44:47], v[48:51], v[224:227]
  ds_read_b128 v[104:107], v14 offset:4096
  v_mfma_f32_16x16x32_bf16 v[136:139], v[32:35], v[52:55], v[136:139]
  ds_read_b128 v[108:111], v14 offset:6144
  v_mfma_f32_16x16x32_bf16 v[168:171], v[36:39], v[52:55], v[168:171]
  ds_read_b128 v[116:119], v15 offset:9216
  v_mfma_f32_16x16x32_bf16 v[200:203], v[40:43], v[52:55], v[200:203]
  ds_read_b128 v[120:123], v15 offset:10240
  v_mfma_f32_16x16x32_bf16 v[232:235], v[44:47], v[52:55], v[232:235]
  ds_read_b128 v[124:127], v15 offset:11264
  v_mfma_f32_16x16x32_bf16 v[144:147], v[32:35], v[56:59], v[144:147]
  v_mfma_f32_16x16x32_bf16 v[176:179], v[36:39], v[56:59], v[176:179]
  v_mfma_f32_16x16x32_bf16 v[208:211], v[40:43], v[56:59], v[208:211]
  v_mfma_f32_16x16x32_bf16 v[240:243], v[44:47], v[56:59], v[240:243]
  v_mfma_f32_16x16x32_bf16 v[152:155], v[32:35], v[60:63], v[152:155]
  v_mfma_f32_16x16x32_bf16 v[184:187], v[36:39], v[60:63], v[184:187]
  v_mfma_f32_16x16x32_bf16 v[216:219], v[40:43], v[60:63], v[216:219]
  v_mfma_f32_16x16x32_bf16 v[248:251], v[44:47], v[60:63], v[248:251]
  s_waitcnt lgkmcnt(0)
  s_barrier
  v_mfma_f32_16x16x32_bf16 v[128:131], v[96:99], v[112:115], v[128:131]
  ds_read_b128 v[32:35], v16 offset:0
  v_mfma_f32_16x16x32_bf16 v[160:163], v[100:103], v[112:115], v[160:163]
  ds_read_b128 v[48:51], v18 offset:0
  v_mfma_f32_16x16x32_bf16 v[192:195], v[104:107], v[112:115], v[192:195]
  ds_read_b128 v[36:39], v16 offset:2048
  v_mfma_f32_16x16x32_bf16 v[224:227], v[108:111], v[112:115], v[224:227]
  ds_read_b128 v[40:43], v16 offset:4096
  v_mfma_f32_16x16x32_bf16 v[136:139], v[96:99], v[116:119], v[136:139]
  ds_read_b128 v[44:47], v16 offset:6144
  v_mfma_f32_16x16x32_bf16 v[168:171], v[100:103], v[116:119], v[168:171]
  ds_read_b128 v[52:55], v18 offset:1024
  v_mfma_f32_16x16x32_bf16 v[200:203], v[104:107], v[116:119], v[200:203]
  ds_read_b128 v[56:59], v18 offset:2048
  v_mfma_f32_16x16x32_bf16 v[232:235], v[108:111], v[116:119], v[232:235]
  ds_read_b128 v[60:63], v18 offset:3072
  v_mfma_f32_16x16x32_bf16 v[144:147], v[96:99], v[120:123], v[144:147]
  v_mfma_f32_16x16x32_bf16 v[176:179], v[100:103], v[120:123], v[176:179]
  v_mfma_f32_16x16x32_bf16 v[208:211], v[104:107], v[120:123], v[208:211]
  v_mfma_f32_16x16x32_bf16 v[240:243], v[108:111], v[120:123], v[240:243]
  v_mfma_f32_16x16x32_bf16 v[152:155], v[96:99], v[124:127], v[152:155]
  v_mfma_f32_16x16x32_bf16 v[184:187], v[100:103], v[124:127], v[184:187]
  v_mfma_f32_16x16x32_bf16 v[216:219], v[104:107], v[124:127], v[216:219]
  v_mfma_f32_16x16x32_bf16 v[248:251], v[108:111], v[124:127], v[248:251]
  s_waitcnt lgkmcnt(0)
  v_mfma_f32_16x16x32_bf16 v[128:131], v[32:35], v[48:51], v[128:131]
  ds_read_b128 v[96:99], v17 offset:0
  v_mfma_f32_16x16x32_bf16 v[160:163], v[36:39], v[48:51], v[160:163]
  ds_read_b128 v[112:115], v18 offset:8192
  v_mfma_f32_16x16x32_bf16 v[192:195], v[40:43], v[48:51], v[192:195]
  ds_read_b128 v[100:103], v17 offset:2048
  v_mfma_f32_16x16x32_bf16 v[224:227], v[44:47], v[48:51], v[224:227]
  ds_read_b128 v[104:107], v17 offset:4096
  v_mfma_f32_16x16x32_bf16 v[136:139], v[32:35], v[52:55], v[136:139]
  ds_read_b128 v[108:111], v17 offset:6144
  v_mfma_f32_16x16x32_bf16 v[168:171], v[36:39], v[52:55], v[168:171]
  ds_read_b128 v[116:119], v18 offset:9216
  v_mfma_f32_16x16x32_bf16 v[200:203], v[40:43], v[52:55], v[200:203]
  ds_read_b128 v[120:123], v18 offset:10240
  v_mfma_f32_16x16x32_bf16 v[232:235], v[44:47], v[52:55], v[232:235]
  ds_read_b128 v[124:127], v18 offset:11264
  v_mfma_f32_16x16x32_bf16 v[144:147], v[32:35], v[56:59], v[144:147]
  v_mfma_f32_16x16x32_bf16 v[176:179], v[36:39], v[56:59], v[176:179]
  v_mfma_f32_16x16x32_bf16 v[208:211], v[40:43], v[56:59], v[208:211]
  v_mfma_f32_16x16x32_bf16 v[240:243], v[44:47], v[56:59], v[240:243]
  v_mfma_f32_16x16x32_bf16 v[152:155], v[32:35], v[60:63], v[152:155]
  v_mfma_f32_16x16x32_bf16 v[184:187], v[36:39], v[60:63], v[184:187]
  v_mfma_f32_16x16x32_bf16 v[216:219], v[40:43], v[60:63], v[216:219]
  v_mfma_f32_16x16x32_bf16 v[248:251], v[44:47], v[60:63], v[248:251]
  s_waitcnt lgkmcnt(0)
  v_mfma_f32_16x16x32_bf16 v[128:131], v[96:99], v[112:115], v[128:131]
  ds_read_b128 v[32:35], v10 offset:0
  v_mfma_f32_16x16x32_bf16 v[160:163], v[100:103], v[112:115], v[160:163]
  ds_read_b128 v[48:51], v12 offset:256
  v_mfma_f32_16x16x32_bf16 v[192:195], v[104:107], v[112:115], v[192:195]
  ds_read_b128 v[36:39], v10 offset:2048
  v_mfma_f32_16x16x32_bf16 v[224:227], v[108:111], v[112:115], v[224:227]
  ds_read_b128 v[40:43], v10 offset:4096
  v_mfma_f32_16x16x32_bf16 v[136:139], v[96:99], v[116:119], v[136:139]
  ds_read_b128 v[44:47], v10 offset:6144
  v_mfma_f32_16x16x32_bf16 v[168:171], v[100:103], v[116:119], v[168:171]
  ds_read_b128 v[52:55], v12 offset:1280
  v_mfma_f32_16x16x32_bf16 v[200:203], v[104:107], v[116:119], v[200:203]
  ds_read_b128 v[56:59], v12 offset:2304
  v_mfma_f32_16x16x32_bf16 v[232:235], v[108:111], v[116:119], v[232:235]
  ds_read_b128 v[60:63], v12 offset:3328
  v_mfma_f32_16x16x32_bf16 v[144:147], v[96:99], v[120:123], v[144:147]
  v_mfma_f32_16x16x32_bf16 v[176:179], v[100:103], v[120:123], v[176:179]
  v_mfma_f32_16x16x32_bf16 v[208:211], v[104:107], v[120:123], v[208:211]
  v_mfma_f32_16x16x32_bf16 v[240:243], v[108:111], v[120:123], v[240:243]
  v_mfma_f32_16x16x32_bf16 v[152:155], v[96:99], v[124:127], v[152:155]
  v_mfma_f32_16x16x32_bf16 v[184:187], v[100:103], v[124:127], v[184:187]
  v_mfma_f32_16x16x32_bf16 v[216:219], v[104:107], v[124:127], v[216:219]
  v_mfma_f32_16x16x32_bf16 v[248:251], v[108:111], v[124:127], v[248:251]
  s_waitcnt lgkmcnt(0)
  v_mfma_f32_16x16x32_bf16 v[132:135], v[32:35], v[48:51], v[132:135]
  ds_read_b128 v[96:99], v11 offset:0
  v_mfma_f32_16x16x32_bf16 v[164:167], v[36:39], v[48:51], v[164:167]
  ds_read_b128 v[112:115], v12 offset:8448
  v_mfma_f32_16x16x32_bf16 v[196:199], v[40:43], v[48:51], v[196:199]
  ds_read_b128 v[100:103], v11 offset:2048
  v_mfma_f32_16x16x32_bf16 v[228:231], v[44:47], v[48:51], v[228:231]
  ds_read_b128 v[104:107], v11 offset:4096
  v_mfma_f32_16x16x32_bf16 v[140:143], v[32:35], v[52:55], v[140:143]
  ds_read_b128 v[108:111], v11 offset:6144
  v_mfma_f32_16x16x32_bf16 v[172:175], v[36:39], v[52:55], v[172:175]
  ds_read_b128 v[116:119], v12 offset:9472
  v_mfma_f32_16x16x32_bf16 v[204:207], v[40:43], v[52:55], v[204:207]
  ds_read_b128 v[120:123], v12 offset:10496
  v_mfma_f32_16x16x32_bf16 v[236:239], v[44:47], v[52:55], v[236:239]
  ds_read_b128 v[124:127], v12 offset:11520
  v_mfma_f32_16x16x32_bf16 v[148:151], v[32:35], v[56:59], v[148:151]
  v_cvt_pk_bf16_f32 v64, v128, v136
  v_cvt_pk_bf16_f32 v65, v144, v152
  v_mfma_f32_16x16x32_bf16 v[180:183], v[36:39], v[56:59], v[180:183]
  s_add_u32 s55, s54, 0
  buffer_store_dwordx2 v[64:65], v24, s[16:19], s55 offen offset:0 sc0 sc1
  v_mfma_f32_16x16x32_bf16 v[212:215], v[40:43], v[56:59], v[212:215]
  v_cvt_pk_bf16_f32 v66, v129, v137
  v_cvt_pk_bf16_f32 v67, v145, v153
  v_mfma_f32_16x16x32_bf16 v[244:247], v[44:47], v[56:59], v[244:247]
  s_add_u32 s55, s54, 7168
  buffer_store_dwordx2 v[66:67], v24, s[16:19], s55 offen offset:0 sc0 sc1
  v_mfma_f32_16x16x32_bf16 v[156:159], v[32:35], v[60:63], v[156:159]
  v_cvt_pk_bf16_f32 v68, v130, v138
  v_cvt_pk_bf16_f32 v69, v146, v154
  v_mfma_f32_16x16x32_bf16 v[188:191], v[36:39], v[60:63], v[188:191]
  s_add_u32 s55, s54, 14336
  buffer_store_dwordx2 v[68:69], v24, s[16:19], s55 offen offset:0 sc0 sc1
  v_mfma_f32_16x16x32_bf16 v[220:223], v[40:43], v[60:63], v[220:223]
  v_cvt_pk_bf16_f32 v70, v131, v139
  v_cvt_pk_bf16_f32 v71, v147, v155
  v_mfma_f32_16x16x32_bf16 v[252:255], v[44:47], v[60:63], v[252:255]
  s_add_u32 s55, s54, 21504
  buffer_store_dwordx2 v[70:71], v24, s[16:19], s55 offen offset:0 sc0 sc1
  s_waitcnt lgkmcnt(0)
  v_mfma_f32_16x16x32_bf16 v[132:135], v[96:99], v[112:115], v[132:135]
  ds_read_b128 v[32:35], v13 offset:0
  v_cvt_pk_bf16_f32 v72, v160, v168
  v_mfma_f32_16x16x32_bf16 v[164:167], v[100:103], v[112:115], v[164:167]
  ds_read_b128 v[48:51], v15 offset:256
  v_cvt_pk_bf16_f32 v73, v176, v184
  v_mfma_f32_16x16x32_bf16 v[196:199], v[104:107], v[112:115], v[196:199]
  ds_read_b128 v[36:39], v13 offset:2048
  s_add_u32 s55, s54, 114688
  v_mfma_f32_16x16x32_bf16 v[228:231], v[108:111], v[112:115], v[228:231]
  ds_read_b128 v[40:43], v13 offset:4096
  buffer_store_dwordx2 v[72:73], v24, s[16:19], s55 offen offset:0 sc0 sc1
  v_mfma_f32_16x16x32_bf16 v[140:143], v[96:99], v[116:119], v[140:143]
  ds_read_b128 v[44:47], v13 offset:6144
  v_cvt_pk_bf16_f32 v74, v161, v169
  v_mfma_f32_16x16x32_bf16 v[172:175], v[100:103], v[116:119], v[172:175]
  ds_read_b128 v[52:55], v15 offset:1280
  v_cvt_pk_bf16_f32 v75, v177, v185
  v_mfma_f32_16x16x32_bf16 v[204:207], v[104:107], v[116:119], v[204:207]
  ds_read_b128 v[56:59], v15 offset:2304
  s_add_u32 s55, s54, 121856
  v_mfma_f32_16x16x32_bf16 v[236:239], v[108:111], v[116:119], v[236:239]
  ds_read_b128 v[60:63], v15 offset:3328
  buffer_store_dwordx2 v[74:75], v24, s[16:19], s55 offen offset:0 sc0 sc1
  v_cvt_pk_bf16_f32 v76, v162, v170
  v_mfma_f32_16x16x32_bf16 v[148:151], v[96:99], v[120:123], v[148:151]
  v_cvt_pk_bf16_f32 v77, v178, v186
  s_add_u32 s55, s54, 129024
  v_mfma_f32_16x16x32_bf16 v[180:183], v[100:103], v[120:123], v[180:183]
  buffer_store_dwordx2 v[76:77], v24, s[16:19], s55 offen offset:0 sc0 sc1
  v_cvt_pk_bf16_f32 v78, v163, v171
  v_mfma_f32_16x16x32_bf16 v[212:215], v[104:107], v[120:123], v[212:215]
  v_cvt_pk_bf16_f32 v79, v179, v187
  s_add_u32 s55, s54, 136192
  v_mfma_f32_16x16x32_bf16 v[244:247], v[108:111], v[120:123], v[244:247]
  buffer_store_dwordx2 v[78:79], v24, s[16:19], s55 offen offset:0 sc0 sc1
  v_cvt_pk_bf16_f32 v80, v192, v200
  v_mfma_f32_16x16x32_bf16 v[156:159], v[96:99], v[124:127], v[156:159]
  v_cvt_pk_bf16_f32 v81, v208, v216
  s_add_u32 s55, s54, 229376
  v_mfma_f32_16x16x32_bf16 v[188:191], v[100:103], v[124:127], v[188:191]
  buffer_store_dwordx2 v[80:81], v24, s[16:19], s55 offen offset:0 sc0 sc1
  v_cvt_pk_bf16_f32 v82, v193, v201
  v_mfma_f32_16x16x32_bf16 v[220:223], v[104:107], v[124:127], v[220:223]
  v_cvt_pk_bf16_f32 v83, v209, v217
  s_add_u32 s55, s54, 236544
  v_mfma_f32_16x16x32_bf16 v[252:255], v[108:111], v[124:127], v[252:255]
  buffer_store_dwordx2 v[82:83], v24, s[16:19], s55 offen offset:0 sc0 sc1
  v_cvt_pk_bf16_f32 v84, v194, v202
  s_waitcnt lgkmcnt(0)
  v_mfma_f32_16x16x32_bf16 v[132:135], v[32:35], v[48:51], v[132:135]
  ds_read_b128 v[96:99], v14 offset:0
  v_cvt_pk_bf16_f32 v85, v210, v218
  v_mfma_f32_16x16x32_bf16 v[164:167], v[36:39], v[48:51], v[164:167]
  ds_read_b128 v[112:115], v15 offset:8448
  s_add_u32 s55, s54, 243712
  v_mfma_f32_16x16x32_bf16 v[196:199], v[40:43], v[48:51], v[196:199]
  ds_read_b128 v[100:103], v14 offset:2048
  buffer_store_dwordx2 v[84:85], v24, s[16:19], s55 offen offset:0 sc0 sc1
  v_mfma_f32_16x16x32_bf16 v[228:231], v[44:47], v[48:51], v[228:231]
  ds_read_b128 v[104:107], v14 offset:4096
  v_cvt_pk_bf16_f32 v86, v195, v203
  v_mfma_f32_16x16x32_bf16 v[140:143], v[32:35], v[52:55], v[140:143]
  ds_read_b128 v[108:111], v14 offset:6144
  v_cvt_pk_bf16_f32 v87, v211, v219
  v_mfma_f32_16x16x32_bf16 v[172:175], v[36:39], v[52:55], v[172:175]
  ds_read_b128 v[116:119], v15 offset:9472
  s_add_u32 s55, s54, 250880
  v_mfma_f32_16x16x32_bf16 v[204:207], v[40:43], v[52:55], v[204:207]
  ds_read_b128 v[120:123], v15 offset:10496
  buffer_store_dwordx2 v[86:87], v24, s[16:19], s55 offen offset:0 sc0 sc1
  v_mfma_f32_16x16x32_bf16 v[236:239], v[44:47], v[52:55], v[236:239]
  ds_read_b128 v[124:127], v15 offset:11520
  v_cvt_pk_bf16_f32 v88, v224, v232
  v_cvt_pk_bf16_f32 v89, v240, v248
  v_mfma_f32_16x16x32_bf16 v[148:151], v[32:35], v[56:59], v[148:151]
  s_add_u32 s55, s54, 344064
  buffer_store_dwordx2 v[88:89], v24, s[16:19], s55 offen offset:0 sc0 sc1
  v_mfma_f32_16x16x32_bf16 v[180:183], v[36:39], v[56:59], v[180:183]
  v_cvt_pk_bf16_f32 v90, v225, v233
  v_cvt_pk_bf16_f32 v91, v241, v249
  v_mfma_f32_16x16x32_bf16 v[212:215], v[40:43], v[56:59], v[212:215]
  s_add_u32 s55, s54, 351232
  buffer_store_dwordx2 v[90:91], v24, s[16:19], s55 offen offset:0 sc0 sc1
  v_mfma_f32_16x16x32_bf16 v[244:247], v[44:47], v[56:59], v[244:247]
  v_cvt_pk_bf16_f32 v92, v226, v234
  v_cvt_pk_bf16_f32 v93, v242, v250
  v_mfma_f32_16x16x32_bf16 v[156:159], v[32:35], v[60:63], v[156:159]
  s_add_u32 s55, s54, 358400
  buffer_store_dwordx2 v[92:93], v24, s[16:19], s55 offen offset:0 sc0 sc1
  v_mfma_f32_16x16x32_bf16 v[188:191], v[36:39], v[60:63], v[188:191]
  v_cvt_pk_bf16_f32 v94, v227, v235
  v_cvt_pk_bf16_f32 v95, v243, v251
  v_mfma_f32_16x16x32_bf16 v[220:223], v[40:43], v[60:63], v[220:223]
  s_add_u32 s55, s54, 365568
  buffer_store_dwordx2 v[94:95], v24, s[16:19], s55 offen offset:0 sc0 sc1
  v_mfma_f32_16x16x32_bf16 v[252:255], v[44:47], v[60:63], v[252:255]
  s_waitcnt lgkmcnt(0)
  v_mfma_f32_16x16x32_bf16 v[132:135], v[96:99], v[112:115], v[132:135]
  ds_read_b128 v[32:35], v16 offset:0
  v_mfma_f32_16x16x32_bf16 v[164:167], v[100:103], v[112:115], v[164:167]
  ds_read_b128 v[48:51], v18 offset:256
  v_mfma_f32_16x16x32_bf16 v[196:199], v[104:107], v[112:115], v[196:199]
  ds_read_b128 v[36:39], v16 offset:2048
  v_mfma_f32_16x16x32_bf16 v[228:231], v[108:111], v[112:115], v[228:231]
  ds_read_b128 v[40:43], v16 offset:4096
  v_mfma_f32_16x16x32_bf16 v[140:143], v[96:99], v[116:119], v[140:143]
  ds_read_b128 v[44:47], v16 offset:6144
  v_mfma_f32_16x16x32_bf16 v[172:175], v[100:103], v[116:119], v[172:175]
  ds_read_b128 v[52:55], v18 offset:1280
  v_mfma_f32_16x16x32_bf16 v[204:207], v[104:107], v[116:119], v[204:207]
  ds_read_b128 v[56:59], v18 offset:2304
  v_mfma_f32_16x16x32_bf16 v[236:239], v[108:111], v[116:119], v[236:239]
  ds_read_b128 v[60:63], v18 offset:3328
  v_mfma_f32_16x16x32_bf16 v[148:151], v[96:99], v[120:123], v[148:151]
  v_mfma_f32_16x16x32_bf16 v[180:183], v[100:103], v[120:123], v[180:183]
  v_mfma_f32_16x16x32_bf16 v[212:215], v[104:107], v[120:123], v[212:215]
  v_mfma_f32_16x16x32_bf16 v[244:247], v[108:111], v[120:123], v[244:247]
  v_mfma_f32_16x16x32_bf16 v[156:159], v[96:99], v[124:127], v[156:159]
  v_mfma_f32_16x16x32_bf16 v[188:191], v[100:103], v[124:127], v[188:191]
  v_mfma_f32_16x16x32_bf16 v[220:223], v[104:107], v[124:127], v[220:223]
  v_mfma_f32_16x16x32_bf16 v[252:255], v[108:111], v[124:127], v[252:255]
  s_waitcnt lgkmcnt(0)
  v_mfma_f32_16x16x32_bf16 v[132:135], v[32:35], v[48:51], v[132:135]
  ds_read_b128 v[96:99], v17 offset:0
  v_mfma_f32_16x16x32_bf16 v[164:167], v[36:39], v[48:51], v[164:167]
  ds_read_b128 v[112:115], v18 offset:8448
  v_mfma_f32_16x16x32_bf16 v[196:199], v[40:43], v[48:51], v[196:199]
  ds_read_b128 v[100:103], v17 offset:2048
  v_mfma_f32_16x16x32_bf16 v[228:231], v[44:47], v[48:51], v[228:231]
  ds_read_b128 v[104:107], v17 offset:4096
  v_mfma_f32_16x16x32_bf16 v[140:143], v[32:35], v[52:55], v[140:143]
  ds_read_b128 v[108:111], v17 offset:6144
  v_mfma_f32_16x16x32_bf16 v[172:175], v[36:39], v[52:55], v[172:175]
  ds_read_b128 v[116:119], v18 offset:9472
  v_mfma_f32_16x16x32_bf16 v[204:207], v[40:43], v[52:55], v[204:207]
  ds_read_b128 v[120:123], v18 offset:10496
  v_mfma_f32_16x16x32_bf16 v[236:239], v[44:47], v[52:55], v[236:239]
  ds_read_b128 v[124:127], v18 offset:11520
  v_mfma_f32_16x16x32_bf16 v[148:151], v[32:35], v[56:59], v[148:151]
  v_mfma_f32_16x16x32_bf16 v[180:183], v[36:39], v[56:59], v[180:183]
  v_mfma_f32_16x16x32_bf16 v[212:215], v[40:43], v[56:59], v[212:215]
  v_mfma_f32_16x16x32_bf16 v[244:247], v[44:47], v[56:59], v[244:247]
  v_mfma_f32_16x16x32_bf16 v[156:159], v[32:35], v[60:63], v[156:159]
  v_mfma_f32_16x16x32_bf16 v[188:191], v[36:39], v[60:63], v[188:191]
  v_mfma_f32_16x16x32_bf16 v[220:223], v[40:43], v[60:63], v[220:223]
  v_mfma_f32_16x16x32_bf16 v[252:255], v[44:47], v[60:63], v[252:255]
  s_waitcnt lgkmcnt(0)
  v_mfma_f32_16x16x32_bf16 v[132:135], v[96:99], v[112:115], v[132:135]
  v_mfma_f32_16x16x32_bf16 v[164:167], v[100:103], v[112:115], v[164:167]
  v_mfma_f32_16x16x32_bf16 v[196:199], v[104:107], v[112:115], v[196:199]
  v_mfma_f32_16x16x32_bf16 v[228:231], v[108:111], v[112:115], v[228:231]
  v_mfma_f32_16x16x32_bf16 v[140:143], v[96:99], v[116:119], v[140:143]
  v_mfma_f32_16x16x32_bf16 v[172:175], v[100:103], v[116:119], v[172:175]
  v_mfma_f32_16x16x32_bf16 v[204:207], v[104:107], v[116:119], v[204:207]
  v_mfma_f32_16x16x32_bf16 v[236:239], v[108:111], v[116:119], v[236:239]
  v_mfma_f32_16x16x32_bf16 v[148:151], v[96:99], v[120:123], v[148:151]
  v_mfma_f32_16x16x32_bf16 v[180:183], v[100:103], v[120:123], v[180:183]
  v_mfma_f32_16x16x32_bf16 v[212:215], v[104:107], v[120:123], v[212:215]
  v_mfma_f32_16x16x32_bf16 v[244:247], v[108:111], v[120:123], v[244:247]
  v_mfma_f32_16x16x32_bf16 v[156:159], v[96:99], v[124:127], v[156:159]
  v_mfma_f32_16x16x32_bf16 v[188:191], v[100:103], v[124:127], v[188:191]
  v_mfma_f32_16x16x32_bf16 v[220:223], v[104:107], v[124:127], v[220:223]
  v_mfma_f32_16x16x32_bf16 v[252:255], v[108:111], v[124:127], v[252:255]
  s_nop 7
  v_cvt_pk_bf16_f32 v32, v132, v140
  v_cvt_pk_bf16_f32 v33, v148, v156
  s_add_u32 s55, s54, 0
  buffer_store_dwordx2 v[32:33], v24, s[16:19], s55 offen offset:128 sc0 sc1
  v_cvt_pk_bf16_f32 v34, v133, v141
  v_cvt_pk_bf16_f32 v35, v149, v157
  s_add_u32 s55, s54, 7168
  buffer_store_dwordx2 v[34:35], v24, s[16:19], s55 offen offset:128 sc0 sc1
  v_cvt_pk_bf16_f32 v36, v134, v142
  v_cvt_pk_bf16_f32 v37, v150, v158
  s_add_u32 s55, s54, 14336
  buffer_store_dwordx2 v[36:37], v24, s[16:19], s55 offen offset:128 sc0 sc1
  v_cvt_pk_bf16_f32 v38, v135, v143
  v_cvt_pk_bf16_f32 v39, v151, v159
  s_add_u32 s55, s54, 21504
  buffer_store_dwordx2 v[38:39], v24, s[16:19], s55 offen offset:128 sc0 sc1
  v_cvt_pk_bf16_f32 v40, v164, v172
  v_cvt_pk_bf16_f32 v41, v180, v188
  s_add_u32 s55, s54, 114688
  buffer_store_dwordx2 v[40:41], v24, s[16:19], s55 offen offset:128 sc0 sc1
  v_cvt_pk_bf16_f32 v42, v165, v173
  v_cvt_pk_bf16_f32 v43, v181, v189
  s_add_u32 s55, s54, 121856
  buffer_store_dwordx2 v[42:43], v24, s[16:19], s55 offen offset:128 sc0 sc1
  v_cvt_pk_bf16_f32 v44, v166, v174
  v_cvt_pk_bf16_f32 v45, v182, v190
  s_add_u32 s55, s54, 129024
  buffer_store_dwordx2 v[44:45], v24, s[16:19], s55 offen offset:128 sc0 sc1
  v_cvt_pk_bf16_f32 v46, v167, v175
  v_cvt_pk_bf16_f32 v47, v183, v191
  s_add_u32 s55, s54, 136192
  buffer_store_dwordx2 v[46:47], v24, s[16:19], s55 offen offset:128 sc0 sc1
  v_cvt_pk_bf16_f32 v48, v196, v204
  v_cvt_pk_bf16_f32 v49, v212, v220
  s_add_u32 s55, s54, 229376
  buffer_store_dwordx2 v[48:49], v24, s[16:19], s55 offen offset:128 sc0 sc1
  v_cvt_pk_bf16_f32 v50, v197, v205
  v_cvt_pk_bf16_f32 v51, v213, v221
  s_add_u32 s55, s54, 236544
  buffer_store_dwordx2 v[50:51], v24, s[16:19], s55 offen offset:128 sc0 sc1
  v_cvt_pk_bf16_f32 v52, v198, v206
  v_cvt_pk_bf16_f32 v53, v214, v222
  s_add_u32 s55, s54, 243712
  buffer_store_dwordx2 v[52:53], v24, s[16:19], s55 offen offset:128 sc0 sc1
  v_cvt_pk_bf16_f32 v54, v199, v207
  v_cvt_pk_bf16_f32 v55, v215, v223
  s_add_u32 s55, s54, 250880
  buffer_store_dwordx2 v[54:55], v24, s[16:19], s55 offen offset:128 sc0 sc1
  v_cvt_pk_bf16_f32 v56, v228, v236
  v_cvt_pk_bf16_f32 v57, v244, v252
  s_add_u32 s55, s54, 344064
  buffer_store_dwordx2 v[56:57], v24, s[16:19], s55 offen offset:128 sc0 sc1
  v_cvt_pk_bf16_f32 v58, v229, v237
  v_cvt_pk_bf16_f32 v59, v245, v253
  s_add_u32 s55, s54, 351232
  buffer_store_dwordx2 v[58:59], v24, s[16:19], s55 offen offset:128 sc0 sc1
  v_cvt_pk_bf16_f32 v60, v230, v238
  v_cvt_pk_bf16_f32 v61, v246, v254
  s_add_u32 s55, s54, 358400
  buffer_store_dwordx2 v[60:61], v24, s[16:19], s55 offen offset:128 sc0 sc1
  v_cvt_pk_bf16_f32 v62, v231, v239
  v_cvt_pk_bf16_f32 v63, v247, v255
  s_add_u32 s55, s54, 365568
  buffer_store_dwordx2 v[62:63], v24, s[16:19], s55 offen offset:128 sc0 sc1
L_end:
  s_endpgm
.section .rodata,"a"
.p2align 6
.amdhsa_kernel standalone__normalfloat_lut_codebook_lookup__prompt_kernel
  .amdhsa_next_free_vgpr 256
  .amdhsa_next_free_sgpr 102
  .amdhsa_accum_offset 256
  .amdhsa_group_segment_fixed_size 0
  .amdhsa_kernarg_size 56
  .amdhsa_user_sgpr_count 2
  .amdhsa_user_sgpr_kernarg_segment_ptr 1
  .amdhsa_system_sgpr_workgroup_id_x 1
  .amdhsa_float_denorm_mode_32 3
  .amdhsa_float_denorm_mode_16_64 3
.end_amdhsa_kernel
```
